```python
import torch

def _softmax(x, axis=-1):
    return torch.softmax(x, dim=axis)
def _gelu(x):
    return torch.nn.functional.gelu(x, approximate="tanh")
def _silu(x):
    return torch.nn.functional.silu(x)
def _sigmoid(x):
    return torch.sigmoid(x)
def _layernorm(x, axis=-1, eps=1e-5):
    m = x.mean(dim=axis, keepdim=True)
    v = x.var(dim=axis, keepdim=True, unbiased=False)
    return (x - m) / torch.sqrt(v + eps)
def _scatter_add(tgt, idx, src, axis=0):
    return tgt.clone().index_add_(axis, idx, src)
def _segment_sum(src, seg, n):
    out = torch.zeros((n,) + src.shape[1:], dtype=src.dtype)
    return out.index_add_(0, seg, src)
def _pad(x, pw):
    flat = tuple(v for pair in reversed(pw) for v in pair)
    return torch.nn.functional.pad(x, flat)

kernel_name = 'standalone__gqa_softmax__decode'

def setup_inputs():

    _w = (lambda a: (lambda t: t.to(torch.bfloat16) if t.is_floating_point() else t)(torch.as_tensor(a)))
    B, Hq, Hkv, Sq, Sk, D = 1, 32, 32, 1, 32768, 128
    return {
        "q": _w((lambda *s: torch.randn(*s, dtype=torch.bfloat16) * 0.8)(B, Hq, Sq, D)),
        "k": _w((lambda *s: torch.randn(*s, dtype=torch.bfloat16) * 0.8)(B, Hkv, Sk, D)),
        "v": _w((lambda *s: torch.randn(*s, dtype=torch.bfloat16) * 0.05)(B, Hkv, Sk, D)),
    }

def reference(q, k, v):
    B, Hq, Sq, D = q.shape
    Hkv = k.shape[1]
    rep = Hq // Hkv
    k = (lambda x, n, axis: torch.repeat_interleave(x, n, dim=axis))(k, rep, axis=1)
    v = (lambda x, n, axis: torch.repeat_interleave(x, n, dim=axis))(v, rep, axis=1)
    scale = D ** -0.5
    scores = torch.einsum("bhqd,bhkd->bhqk", q, k) * scale
    p = _softmax(scores, axis=-1)
    return torch.einsum("bhqk,bhkd->bhqd", p, v)
```

```asm
; @launch grid=(256,1,1) block=(64,1,1) lds=132616
.amdgcn_target "amdgcn-amd-amdhsa--gfx950"
.text
.globl standalone__gqa_softmax__decode_kernel
.p2align 8
.type standalone__gqa_softmax__decode_kernel,@function
standalone__gqa_softmax__decode_kernel:
    s_cmp_ge_u32 s2, 256
    s_cbranch_scc1 L_end
    s_load_dwordx8 s[4:11], s[0:1], 0
    s_load_dwordx4 s[12:15], s[0:1], 32
    s_and_b32 s37, s2, 0xf1
    s_lshl_b32 s37, s37, 20
    s_bitcmp1_b32 s2, 1
    s_cselect_b32 s33, 0x400000, 0
    s_xor_b32 s37, s37, s33
    s_bitcmp1_b32 s2, 2
    s_cselect_b32 s33, 0x800000, 0
    s_xor_b32 s37, s37, s33
    s_bitcmp1_b32 s2, 3
    s_cselect_b32 s33, 0x200000, 0
    s_xor_b32 s37, s37, s33
    s_lshr_b32 s28, s37, 23
    s_bfe_u32 s29, s37, 0x30014
    v_lshrrev_b32 v6, 3, v0
    v_and_b32 v7, 7, v0
    v_lshlrev_b32 v7, 4, v7
    v_lshl_add_u32 v1, v6, 8, v7
    s_mov_b32 s30, s37
    s_lshl_b32 s36, s28, 8
    s_mov_b32 s19, 0x20000
    s_mov_b32 s23, 0x20000
    s_mov_b32 s27, 0x20000
    s_mov_b32 s26, 8192
    s_mov_b32 s18, 268435456
    s_mov_b32 s22, 256
    s_waitcnt lgkmcnt(0)
    s_and_b32 s7, s7, 0xffff
    s_mov_b64 s[16:17], s[6:7]
    s_mov_b32 s24, s4
    s_and_b32 s25, s5, 0xffff
    buffer_load_dwordx4 v[32:35], v7, s[24:27], s36 offen
    buffer_load_dwordx4 v[36:39], v7, s[24:27], s36 offen offset:128
    buffer_load_dwordx4 v[100:103], v1, s[16:19], s30 offen offset:0 nt
    buffer_load_dwordx4 v[104:107], v1, s[16:19], s30 offen offset:128 nt
    buffer_load_dwordx4 v[108:111], v1, s[16:19], s30 offen offset:2048 nt
    buffer_load_dwordx4 v[112:115], v1, s[16:19], s30 offen offset:2176 nt
    s_add_u32 s30, s30, 4096
    buffer_load_dwordx4 v[116:119], v1, s[16:19], s30 offen offset:0 nt
    buffer_load_dwordx4 v[120:123], v1, s[16:19], s30 offen offset:128 nt
    buffer_load_dwordx4 v[124:127], v1, s[16:19], s30 offen offset:2048 nt
    buffer_load_dwordx4 v[128:131], v1, s[16:19], s30 offen offset:2176 nt
    s_add_u32 s30, s30, 4096
    buffer_load_dwordx4 v[132:135], v1, s[16:19], s30 offen offset:0 nt
    buffer_load_dwordx4 v[136:139], v1, s[16:19], s30 offen offset:128 nt
    buffer_load_dwordx4 v[140:143], v1, s[16:19], s30 offen offset:2048 nt
    buffer_load_dwordx4 v[144:147], v1, s[16:19], s30 offen offset:2176 nt
    s_add_u32 s30, s30, 4096
    buffer_load_dwordx4 v[148:151], v1, s[16:19], s30 offen offset:0 nt
    buffer_load_dwordx4 v[152:155], v1, s[16:19], s30 offen offset:128 nt
    buffer_load_dwordx4 v[156:159], v1, s[16:19], s30 offen offset:2048 nt
    buffer_load_dwordx4 v[160:163], v1, s[16:19], s30 offen offset:2176 nt
    s_add_u32 s30, s30, 4096
    buffer_load_dwordx4 v[164:167], v1, s[16:19], s30 offen offset:0 nt
    buffer_load_dwordx4 v[168:171], v1, s[16:19], s30 offen offset:128 nt
    buffer_load_dwordx4 v[172:175], v1, s[16:19], s30 offen offset:2048 nt
    buffer_load_dwordx4 v[176:179], v1, s[16:19], s30 offen offset:2176 nt
    s_add_u32 s30, s30, 4096
    buffer_load_dwordx4 v[180:183], v1, s[16:19], s30 offen offset:0 nt
    buffer_load_dwordx4 v[184:187], v1, s[16:19], s30 offen offset:128 nt
    buffer_load_dwordx4 v[188:191], v1, s[16:19], s30 offen offset:2048 nt
    buffer_load_dwordx4 v[192:195], v1, s[16:19], s30 offen offset:2176 nt
    s_add_u32 s30, s30, 4096
    buffer_load_dwordx4 v[196:199], v1, s[16:19], s30 offen offset:0 nt
    buffer_load_dwordx4 v[200:203], v1, s[16:19], s30 offen offset:128 nt
    buffer_load_dwordx4 v[204:207], v1, s[16:19], s30 offen offset:2048 nt
    buffer_load_dwordx4 v[208:211], v1, s[16:19], s30 offen offset:2176 nt
    s_add_u32 s30, s30, 4096
    buffer_load_dwordx4 v[212:215], v1, s[16:19], s30 offen offset:0 nt
    buffer_load_dwordx4 v[216:219], v1, s[16:19], s30 offen offset:128 nt
    buffer_load_dwordx4 v[220:223], v1, s[16:19], s30 offen offset:2048 nt
    buffer_load_dwordx4 v[224:227], v1, s[16:19], s30 offen offset:2176 nt
    s_add_u32 s30, s30, 4096
    s_and_b32 s9, s9, 0xffff
    s_mov_b32 s20, s12
    s_and_b32 s21, s13, 0xffff
    s_mov_b32 s32, 0x3e0293ee
    s_lshl_b32 s35, s28, 3
    v_mov_b32 v5, 0xff800000
    v_mov_b32 v4, 0
    v_mov_b32 v11, 0
    v_mov_b32 v20, 0
    v_mov_b32 v21, 0
    v_mov_b32 v22, 0
    v_mov_b32 v23, 0
    v_mov_b32 v24, 0
    v_mov_b32 v25, 0
    v_mov_b32 v26, 0
    v_mov_b32 v27, 0
    v_lshlrev_b32 v8, 3, v0
    v_lshlrev_b32 v12, 4, v0
    v_and_b32 v6, 7, v0
    v_and_b32 v7, 1, v0
    v_lshlrev_b32 v7, 4, v7
    v_mov_b32 v2, 0xffff
    v_lshlrev_b32 v7, v7, v2
    v_lshrrev_b32 v6, 1, v6
    v_cmp_eq_u32 vcc, 0, v6
    s_nop 1
    v_cndmask_b32 v28, 0, v7, vcc
    v_cmp_eq_u32 vcc, 1, v6
    s_nop 1
    v_cndmask_b32 v29, 0, v7, vcc
    v_cmp_eq_u32 vcc, 2, v6
    s_nop 1
    v_cndmask_b32 v30, 0, v7, vcc
    v_cmp_eq_u32 vcc, 3, v6
    s_nop 1
    v_cndmask_b32 v31, 0, v7, vcc
    v_mov_b32 v9, v8
    s_mov_b32 s31, 32
    s_mov_b32 s72, s14
    s_and_b32 s73, s15, 0xffff
    s_mov_b32 s74, 1081344
    s_mov_b32 s75, 0x20000
    s_and_b32 s33, s2, 7
    s_lshl_b32 s33, s33, 12
    s_add_u32 s33, s33, 1048576
    s_lshr_b32 s34, s2, 3
    s_lshl_b32 s34, s34, 7
    s_add_u32 s34, s34, s33
    v_lshl_add_u32 v16, v0, 7, s33
    v_lshl_add_u32 v17, v0, 2, s34
    v_cmp_gt_u32 vcc, 32, v0
    s_nop 1
    v_cndmask_b32 v16, -16, v16, vcc
    v_cmp_gt_u32 vcc, 32, v0
    s_nop 1
    v_cndmask_b32 v17, -16, v17, vcc
    v_mov_b32 v14, 0x6b8b4540
    v_mov_b32 v15, 0
    s_mov_b32 s76, 0x55251101
    s_mov_b32 s77, 0xff7f775b
    s_getreg_b32 s78, hwreg(HW_REG_XCC_ID, 0, 1)
    s_cmp_eq_u32 s78, 0
    s_cselect_b32 s78, 12, 0
    s_mov_b32 s43, 0
    .p2align 6
L_k:
    s_cmp_eq_u32 s31, 1
    s_cselect_b64 s[16:17], s[8:9], s[6:7]
    s_cselect_b32 s30, s37, s30
    s_cselect_b32 s43, 255, s43
L_k0:
    s_waitcnt vmcnt(22)
    s_bitcmp1_b32 s43, 0
    s_cbranch_scc1 L_wk0
    s_waitcnt vmcnt(18)
L_wk0:
    v_dot2_f32_bf16 v40, v100, v32, 0
    v_dot2_f32_bf16 v41, v108, v32, 0
    v_dot2_f32_bf16 v40, v101, v33, v40
    v_dot2_f32_bf16 v41, v109, v33, v41
    v_dot2_f32_bf16 v40, v102, v34, v40
    v_dot2_f32_bf16 v41, v110, v34, v41
    v_dot2_f32_bf16 v40, v103, v35, v40
    v_dot2_f32_bf16 v41, v111, v35, v41
    v_dot2_f32_bf16 v40, v104, v36, v40
    v_dot2_f32_bf16 v41, v112, v36, v41
    v_dot2_f32_bf16 v40, v105, v37, v40
    v_dot2_f32_bf16 v41, v113, v37, v41
    v_dot2_f32_bf16 v40, v106, v38, v40
    v_dot2_f32_bf16 v41, v114, v38, v41
    v_dot2_f32_bf16 v40, v107, v39, v40
    v_dot2_f32_bf16 v41, v115, v39, v41
    buffer_load_dwordx4 v[100:103], v1, s[16:19], s30 offen offset:0 nt
    buffer_load_dwordx4 v[104:107], v1, s[16:19], s30 offen offset:128 nt
    buffer_load_dwordx4 v[108:111], v1, s[16:19], s30 offen offset:2048 nt
    buffer_load_dwordx4 v[112:115], v1, s[16:19], s30 offen offset:2176 nt
    s_and_b32 s46, s31, 3
    s_cbranch_scc1 L_lf1
    v_add_u32 v14, 1, v14
    buffer_store_dword v14, v17, s[72:75], 0 offen
L_lf1:
    s_add_u32 s30, s30, 4096
    v_add_f32_dpp v40, v40, v40 quad_perm:[1,0,3,2] row_mask:0xf bank_mask:0xf
    v_add_f32_dpp v41, v41, v41 quad_perm:[1,0,3,2] row_mask:0xf bank_mask:0xf
    s_nop 0
    v_add_f32_dpp v40, v40, v40 quad_perm:[2,3,0,1] row_mask:0xf bank_mask:0xf
    v_add_f32_dpp v41, v41, v41 quad_perm:[2,3,0,1] row_mask:0xf bank_mask:0xf
    s_nop 0
    v_add_f32_dpp v40, v40, v40 row_half_mirror row_mask:0xf bank_mask:0xf
    v_add_f32_dpp v41, v41, v41 row_half_mirror row_mask:0xf bank_mask:0xf
    ds_write_b64 v9, v[40:41] offset:0
    v_max3_f32 v5, v5, v40, v41
    s_waitcnt vmcnt(22)
    s_bitcmp1_b32 s43, 1
    s_cbranch_scc1 L_wk1
    s_waitcnt vmcnt(18)
L_wk1:
    v_dot2_f32_bf16 v40, v116, v32, 0
    v_dot2_f32_bf16 v41, v124, v32, 0
    v_dot2_f32_bf16 v40, v117, v33, v40
    v_dot2_f32_bf16 v41, v125, v33, v41
    v_dot2_f32_bf16 v40, v118, v34, v40
    v_dot2_f32_bf16 v41, v126, v34, v41
    v_dot2_f32_bf16 v40, v119, v35, v40
    v_dot2_f32_bf16 v41, v127, v35, v41
    v_dot2_f32_bf16 v40, v120, v36, v40
    v_dot2_f32_bf16 v41, v128, v36, v41
    v_dot2_f32_bf16 v40, v121, v37, v40
    v_dot2_f32_bf16 v41, v129, v37, v41
    v_dot2_f32_bf16 v40, v122, v38, v40
    v_dot2_f32_bf16 v41, v130, v38, v41
    v_dot2_f32_bf16 v40, v123, v39, v40
    v_dot2_f32_bf16 v41, v131, v39, v41
    buffer_load_dwordx4 v[116:119], v1, s[16:19], s30 offen offset:0 nt
    buffer_load_dwordx4 v[120:123], v1, s[16:19], s30 offen offset:128 nt
    buffer_load_dwordx4 v[124:127], v1, s[16:19], s30 offen offset:2048 nt
    buffer_load_dwordx4 v[128:131], v1, s[16:19], s30 offen offset:2176 nt
    s_add_u32 s30, s30, 4096
    v_add_f32_dpp v40, v40, v40 quad_perm:[1,0,3,2] row_mask:0xf bank_mask:0xf
    v_add_f32_dpp v41, v41, v41 quad_perm:[1,0,3,2] row_mask:0xf bank_mask:0xf
    s_nop 0
    v_add_f32_dpp v40, v40, v40 quad_perm:[2,3,0,1] row_mask:0xf bank_mask:0xf
    v_add_f32_dpp v41, v41, v41 quad_perm:[2,3,0,1] row_mask:0xf bank_mask:0xf
    s_nop 0
    v_add_f32_dpp v40, v40, v40 row_half_mirror row_mask:0xf bank_mask:0xf
    v_add_f32_dpp v41, v41, v41 row_half_mirror row_mask:0xf bank_mask:0xf
    ds_write_b64 v9, v[40:41] offset:512
    v_max3_f32 v5, v5, v40, v41
    s_waitcnt vmcnt(22)
    s_bitcmp1_b32 s43, 2
    s_cbranch_scc1 L_wk2
    s_waitcnt vmcnt(18)
L_wk2:
    v_dot2_f32_bf16 v40, v132, v32, 0
    v_dot2_f32_bf16 v41, v140, v32, 0
    v_dot2_f32_bf16 v40, v133, v33, v40
    v_dot2_f32_bf16 v41, v141, v33, v41
    v_dot2_f32_bf16 v40, v134, v34, v40
    v_dot2_f32_bf16 v41, v142, v34, v41
    v_dot2_f32_bf16 v40, v135, v35, v40
    v_dot2_f32_bf16 v41, v143, v35, v41
    v_dot2_f32_bf16 v40, v136, v36, v40
    v_dot2_f32_bf16 v41, v144, v36, v41
    v_dot2_f32_bf16 v40, v137, v37, v40
    v_dot2_f32_bf16 v41, v145, v37, v41
    v_dot2_f32_bf16 v40, v138, v38, v40
    v_dot2_f32_bf16 v41, v146, v38, v41
    v_dot2_f32_bf16 v40, v139, v39, v40
    v_dot2_f32_bf16 v41, v147, v39, v41
    buffer_load_dwordx4 v[132:135], v1, s[16:19], s30 offen offset:0 nt
    buffer_load_dwordx4 v[136:139], v1, s[16:19], s30 offen offset:128 nt
    buffer_load_dwordx4 v[140:143], v1, s[16:19], s30 offen offset:2048 nt
    buffer_load_dwordx4 v[144:147], v1, s[16:19], s30 offen offset:2176 nt
    s_add_u32 s30, s30, 4096
    v_add_f32_dpp v40, v40, v40 quad_perm:[1,0,3,2] row_mask:0xf bank_mask:0xf
    v_add_f32_dpp v41, v41, v41 quad_perm:[1,0,3,2] row_mask:0xf bank_mask:0xf
    s_nop 0
    v_add_f32_dpp v40, v40, v40 quad_perm:[2,3,0,1] row_mask:0xf bank_mask:0xf
    v_add_f32_dpp v41, v41, v41 quad_perm:[2,3,0,1] row_mask:0xf bank_mask:0xf
    s_nop 0
    v_add_f32_dpp v40, v40, v40 row_half_mirror row_mask:0xf bank_mask:0xf
    v_add_f32_dpp v41, v41, v41 row_half_mirror row_mask:0xf bank_mask:0xf
    ds_write_b64 v9, v[40:41] offset:1024
    v_max3_f32 v5, v5, v40, v41
    s_waitcnt vmcnt(22)
    s_bitcmp1_b32 s43, 3
    s_cbranch_scc1 L_wk3
    s_waitcnt vmcnt(18)
L_wk3:
    v_dot2_f32_bf16 v40, v148, v32, 0
    v_dot2_f32_bf16 v41, v156, v32, 0
    v_dot2_f32_bf16 v40, v149, v33, v40
    v_dot2_f32_bf16 v41, v157, v33, v41
    v_dot2_f32_bf16 v40, v150, v34, v40
    v_dot2_f32_bf16 v41, v158, v34, v41
    v_dot2_f32_bf16 v40, v151, v35, v40
    v_dot2_f32_bf16 v41, v159, v35, v41
    v_dot2_f32_bf16 v40, v152, v36, v40
    v_dot2_f32_bf16 v41, v160, v36, v41
    v_dot2_f32_bf16 v40, v153, v37, v40
    v_dot2_f32_bf16 v41, v161, v37, v41
    v_dot2_f32_bf16 v40, v154, v38, v40
    v_dot2_f32_bf16 v41, v162, v38, v41
    v_dot2_f32_bf16 v40, v155, v39, v40
    v_dot2_f32_bf16 v41, v163, v39, v41
    buffer_load_dwordx4 v[148:151], v1, s[16:19], s30 offen offset:0 nt
    buffer_load_dwordx4 v[152:155], v1, s[16:19], s30 offen offset:128 nt
    buffer_load_dwordx4 v[156:159], v1, s[16:19], s30 offen offset:2048 nt
    buffer_load_dwordx4 v[160:163], v1, s[16:19], s30 offen offset:2176 nt
    s_add_u32 s30, s30, 4096
    v_add_f32_dpp v40, v40, v40 quad_perm:[1,0,3,2] row_mask:0xf bank_mask:0xf
    v_add_f32_dpp v41, v41, v41 quad_perm:[1,0,3,2] row_mask:0xf bank_mask:0xf
    s_nop 0
    v_add_f32_dpp v40, v40, v40 quad_perm:[2,3,0,1] row_mask:0xf bank_mask:0xf
    v_add_f32_dpp v41, v41, v41 quad_perm:[2,3,0,1] row_mask:0xf bank_mask:0xf
    s_nop 0
    v_add_f32_dpp v40, v40, v40 row_half_mirror row_mask:0xf bank_mask:0xf
    v_add_f32_dpp v41, v41, v41 row_half_mirror row_mask:0xf bank_mask:0xf
    ds_write_b64 v9, v[40:41] offset:1536
    v_max3_f32 v5, v5, v40, v41
    s_waitcnt vmcnt(22)
    s_bitcmp1_b32 s43, 4
    s_cbranch_scc1 L_wk4
    s_waitcnt vmcnt(18)
L_wk4:
    v_dot2_f32_bf16 v40, v164, v32, 0
    v_dot2_f32_bf16 v41, v172, v32, 0
    v_dot2_f32_bf16 v40, v165, v33, v40
    v_dot2_f32_bf16 v41, v173, v33, v41
    v_dot2_f32_bf16 v40, v166, v34, v40
    v_dot2_f32_bf16 v41, v174, v34, v41
    v_dot2_f32_bf16 v40, v167, v35, v40
    v_dot2_f32_bf16 v41, v175, v35, v41
    v_dot2_f32_bf16 v40, v168, v36, v40
    v_dot2_f32_bf16 v41, v176, v36, v41
    v_dot2_f32_bf16 v40, v169, v37, v40
    v_dot2_f32_bf16 v41, v177, v37, v41
    v_dot2_f32_bf16 v40, v170, v38, v40
    v_dot2_f32_bf16 v41, v178, v38, v41
    v_dot2_f32_bf16 v40, v171, v39, v40
    v_dot2_f32_bf16 v41, v179, v39, v41
    buffer_load_dwordx4 v[164:167], v1, s[16:19], s30 offen offset:0 nt
    buffer_load_dwordx4 v[168:171], v1, s[16:19], s30 offen offset:128 nt
    buffer_load_dwordx4 v[172:175], v1, s[16:19], s30 offen offset:2048 nt
    buffer_load_dwordx4 v[176:179], v1, s[16:19], s30 offen offset:2176 nt
    s_and_b32 s46, s31, 3
    s_cbranch_scc1 L_lf2
    v_sub_u32 v18, v15, v14
    v_cmp_gt_u32 vcc, 8, v18
    v_subrev_u32 v18, 1, v18
    s_bcnt1_i32_b64 s46, vcc
    v_cmp_gt_u32 vcc, 7, v18
    s_nop 0
    s_bcnt1_i32_b64 s47, vcc
    s_add_u32 s46, s46, s47
    s_sub_i32 s46, s46, 2
    s_max_i32 s46, s46, 0
    s_mul_i32 s46, s46, 4
    s_add_u32 s46, s46, s78
    s_min_u32 s46, s46, 71
    s_and_b32 s46, s46, 0xf8
    s_cselect_b32 s43, 0xff, 0
    s_sub_u32 s46, s46, 8
    s_lshr_b64 s[46:47], s[76:77], s46
    s_and_b32 s43, s43, s46
L_lf2:
    s_and_b32 s46, s31, 3
    s_cmp_lg_u32 s46, 1
    s_cbranch_scc1 L_lf3
    buffer_load_dword v15, v16, s[72:75], 0 offen sc1
L_lf3:
    s_add_u32 s30, s30, 4096
    v_add_f32_dpp v40, v40, v40 quad_perm:[1,0,3,2] row_mask:0xf bank_mask:0xf
    v_add_f32_dpp v41, v41, v41 quad_perm:[1,0,3,2] row_mask:0xf bank_mask:0xf
    s_nop 0
    v_add_f32_dpp v40, v40, v40 quad_perm:[2,3,0,1] row_mask:0xf bank_mask:0xf
    v_add_f32_dpp v41, v41, v41 quad_perm:[2,3,0,1] row_mask:0xf bank_mask:0xf
    s_nop 0
    v_add_f32_dpp v40, v40, v40 row_half_mirror row_mask:0xf bank_mask:0xf
    v_add_f32_dpp v41, v41, v41 row_half_mirror row_mask:0xf bank_mask:0xf
    ds_write_b64 v9, v[40:41] offset:2048
    v_max3_f32 v5, v5, v40, v41
    s_waitcnt vmcnt(22)
    s_bitcmp1_b32 s43, 5
    s_cbranch_scc1 L_wk5
    s_waitcnt vmcnt(18)
L_wk5:
    v_dot2_f32_bf16 v40, v180, v32, 0
    v_dot2_f32_bf16 v41, v188, v32, 0
    v_dot2_f32_bf16 v40, v181, v33, v40
    v_dot2_f32_bf16 v41, v189, v33, v41
    v_dot2_f32_bf16 v40, v182, v34, v40
    v_dot2_f32_bf16 v41, v190, v34, v41
    v_dot2_f32_bf16 v40, v183, v35, v40
    v_dot2_f32_bf16 v41, v191, v35, v41
    v_dot2_f32_bf16 v40, v184, v36, v40
    v_dot2_f32_bf16 v41, v192, v36, v41
    v_dot2_f32_bf16 v40, v185, v37, v40
    v_dot2_f32_bf16 v41, v193, v37, v41
    v_dot2_f32_bf16 v40, v186, v38, v40
    v_dot2_f32_bf16 v41, v194, v38, v41
    v_dot2_f32_bf16 v40, v187, v39, v40
    v_dot2_f32_bf16 v41, v195, v39, v41
    buffer_load_dwordx4 v[180:183], v1, s[16:19], s30 offen offset:0 nt
    buffer_load_dwordx4 v[184:187], v1, s[16:19], s30 offen offset:128 nt
    buffer_load_dwordx4 v[188:191], v1, s[16:19], s30 offen offset:2048 nt
    buffer_load_dwordx4 v[192:195], v1, s[16:19], s30 offen offset:2176 nt
    s_add_u32 s30, s30, 4096
    v_add_f32_dpp v40, v40, v40 quad_perm:[1,0,3,2] row_mask:0xf bank_mask:0xf
    v_add_f32_dpp v41, v41, v41 quad_perm:[1,0,3,2] row_mask:0xf bank_mask:0xf
    s_nop 0
    v_add_f32_dpp v40, v40, v40 quad_perm:[2,3,0,1] row_mask:0xf bank_mask:0xf
    v_add_f32_dpp v41, v41, v41 quad_perm:[2,3,0,1] row_mask:0xf bank_mask:0xf
    s_nop 0
    v_add_f32_dpp v40, v40, v40 row_half_mirror row_mask:0xf bank_mask:0xf
    v_add_f32_dpp v41, v41, v41 row_half_mirror row_mask:0xf bank_mask:0xf
    ds_write_b64 v9, v[40:41] offset:2560
    v_max3_f32 v5, v5, v40, v41
    s_waitcnt vmcnt(22)
    s_bitcmp1_b32 s43, 6
    s_cbranch_scc1 L_wk6
    s_waitcnt vmcnt(18)
L_wk6:
    v_dot2_f32_bf16 v40, v196, v32, 0
    v_dot2_f32_bf16 v41, v204, v32, 0
    v_dot2_f32_bf16 v40, v197, v33, v40
    v_dot2_f32_bf16 v41, v205, v33, v41
    v_dot2_f32_bf16 v40, v198, v34, v40
    v_dot2_f32_bf16 v41, v206, v34, v41
    v_dot2_f32_bf16 v40, v199, v35, v40
    v_dot2_f32_bf16 v41, v207, v35, v41
    v_dot2_f32_bf16 v40, v200, v36, v40
    v_dot2_f32_bf16 v41, v208, v36, v41
    v_dot2_f32_bf16 v40, v201, v37, v40
    v_dot2_f32_bf16 v41, v209, v37, v41
    v_dot2_f32_bf16 v40, v202, v38, v40
    v_dot2_f32_bf16 v41, v210, v38, v41
    v_dot2_f32_bf16 v40, v203, v39, v40
    v_dot2_f32_bf16 v41, v211, v39, v41
    buffer_load_dwordx4 v[196:199], v1, s[16:19], s30 offen offset:0 nt
    buffer_load_dwordx4 v[200:203], v1, s[16:19], s30 offen offset:128 nt
    buffer_load_dwordx4 v[204:207], v1, s[16:19], s30 offen offset:2048 nt
    buffer_load_dwordx4 v[208:211], v1, s[16:19], s30 offen offset:2176 nt
    s_add_u32 s30, s30, 4096
    v_add_f32_dpp v40, v40, v40 quad_perm:[1,0,3,2] row_mask:0xf bank_mask:0xf
    v_add_f32_dpp v41, v41, v41 quad_perm:[1,0,3,2] row_mask:0xf bank_mask:0xf
    s_nop 0
    v_add_f32_dpp v40, v40, v40 quad_perm:[2,3,0,1] row_mask:0xf bank_mask:0xf
    v_add_f32_dpp v41, v41, v41 quad_perm:[2,3,0,1] row_mask:0xf bank_mask:0xf
    s_nop 0
    v_add_f32_dpp v40, v40, v40 row_half_mirror row_mask:0xf bank_mask:0xf
    v_add_f32_dpp v41, v41, v41 row_half_mirror row_mask:0xf bank_mask:0xf
    ds_write_b64 v9, v[40:41] offset:3072
    v_max3_f32 v5, v5, v40, v41
    s_waitcnt vmcnt(22)
    s_bitcmp1_b32 s43, 7
    s_cbranch_scc1 L_wk7
    s_waitcnt vmcnt(18)
L_wk7:
    v_dot2_f32_bf16 v40, v212, v32, 0
    v_dot2_f32_bf16 v41, v220, v32, 0
    v_dot2_f32_bf16 v40, v213, v33, v40
    v_dot2_f32_bf16 v41, v221, v33, v41
    v_dot2_f32_bf16 v40, v214, v34, v40
    v_dot2_f32_bf16 v41, v222, v34, v41
    v_dot2_f32_bf16 v40, v215, v35, v40
    v_dot2_f32_bf16 v41, v223, v35, v41
    v_dot2_f32_bf16 v40, v216, v36, v40
    v_dot2_f32_bf16 v41, v224, v36, v41
    v_dot2_f32_bf16 v40, v217, v37, v40
    v_dot2_f32_bf16 v41, v225, v37, v41
    v_dot2_f32_bf16 v40, v218, v38, v40
    v_dot2_f32_bf16 v41, v226, v38, v41
    v_dot2_f32_bf16 v40, v219, v39, v40
    v_dot2_f32_bf16 v41, v227, v39, v41
    buffer_load_dwordx4 v[212:215], v1, s[16:19], s30 offen offset:0 nt
    buffer_load_dwordx4 v[216:219], v1, s[16:19], s30 offen offset:128 nt
    buffer_load_dwordx4 v[220:223], v1, s[16:19], s30 offen offset:2048 nt
    buffer_load_dwordx4 v[224:227], v1, s[16:19], s30 offen offset:2176 nt
    s_add_u32 s30, s30, 4096
    v_add_f32_dpp v40, v40, v40 quad_perm:[1,0,3,2] row_mask:0xf bank_mask:0xf
    v_add_f32_dpp v41, v41, v41 quad_perm:[1,0,3,2] row_mask:0xf bank_mask:0xf
    s_nop 0
    v_add_f32_dpp v40, v40, v40 quad_perm:[2,3,0,1] row_mask:0xf bank_mask:0xf
    v_add_f32_dpp v41, v41, v41 quad_perm:[2,3,0,1] row_mask:0xf bank_mask:0xf
    s_nop 0
    v_add_f32_dpp v40, v40, v40 row_half_mirror row_mask:0xf bank_mask:0xf
    v_add_f32_dpp v41, v41, v41 row_half_mirror row_mask:0xf bank_mask:0xf
    ds_write_b64 v9, v[40:41] offset:3584
    v_max3_f32 v5, v5, v40, v41
    v_add_u32 v9, 4096, v9
    s_sub_u32 s31, s31, 1
    s_cmp_lg_u32 s31, 0
    s_cbranch_scc1 L_k
L_kdone:
    s_mov_b32 s24, s14
    s_and_b32 s25, s15, 0xffff
    s_mov_b32 s26, 262144
    s_lshr_b32 s56, s37, 10
    s_xor_b32 s57, s56, 1024
    s_xor_b32 s58, s56, 2048
    s_xor_b32 s59, s56, 3072
    s_xor_b32 s60, s56, 4096
    s_xor_b32 s61, s56, 5120
    s_xor_b32 s62, s56, 6144
    s_xor_b32 s63, s56, 7168
    buffer_load_dword v56, v12, s[24:27], s56 offen offset:12 sc1
    buffer_load_dword v57, v12, s[24:27], s57 offen offset:12 sc1
    buffer_load_dword v58, v12, s[24:27], s58 offen offset:12 sc1
    buffer_load_dword v59, v12, s[24:27], s59 offen offset:12 sc1
    buffer_load_dword v60, v12, s[24:27], s60 offen offset:12 sc1
    buffer_load_dword v61, v12, s[24:27], s61 offen offset:12 sc1
    buffer_load_dword v62, v12, s[24:27], s62 offen offset:12 sc1
    buffer_load_dword v63, v12, s[24:27], s63 offen offset:12 sc1
    ds_read_b64 v[44:45], v8
    v_max_f32_dpp v5, v5, v5 row_ror:8 row_mask:0xf bank_mask:0xf
    v_mov_b32 v9, v8
    s_mov_b32 s31, 32
    v_max_f32_dpp v5, v5, v5 row_bcast:15 row_mask:0xa bank_mask:0xf
    s_nop 1
    v_max_f32_dpp v5, v5, v5 row_bcast:31 row_mask:0xc bank_mask:0xf
    s_nop 1
    v_readlane_b32 s33, v5, 63
    s_nop 1
    v_mov_b32 v2, s33
    v_mul_f32 v3, s32, v2
    v_sub_f32 v3, 0, v3
    .p2align 6
L_v:
    s_cmp_le_u32 s31, 3
    s_cbranch_scc1 L_vT
L_v0:
    s_waitcnt lgkmcnt(0)
    ds_read_b64 v[46:47], v9 offset:512
    v_fma_f32 v44, v44, s32, v3
    v_fma_f32 v45, v45, s32, v3
    v_exp_f32 v44, v44
    v_exp_f32 v45, v45
    v_cvt_pk_bf16_f32 v51, v44, v44
    v_add_f32 v4, v4, v44
    v_cvt_pk_bf16_f32 v55, v45, v45
    v_add_f32 v4, v4, v45
    v_and_b32 v48, v51, v28
    v_and_b32 v49, v51, v29
    v_and_b32 v50, v51, v30
    v_and_b32 v51, v51, v31
    v_and_b32 v52, v55, v28
    v_and_b32 v53, v55, v29
    v_and_b32 v54, v55, v30
    v_and_b32 v55, v55, v31
    s_waitcnt vmcnt(22)
    s_bitcmp1_b32 s43, 0
    s_cbranch_scc1 L_wv0
    s_waitcnt vmcnt(18)
L_wv0:
    s_nop 0
    v_mfma_f32_16x16x32_bf16 v[20:23], v[100:103], v[48:51], v[20:23]
    v_mfma_f32_16x16x32_bf16 v[24:27], v[104:107], v[48:51], v[24:27]
    v_mfma_f32_16x16x32_bf16 v[20:23], v[108:111], v[52:55], v[20:23]
    v_mfma_f32_16x16x32_bf16 v[24:27], v[112:115], v[52:55], v[24:27]
    buffer_load_dwordx4 v[100:103], v1, s[16:19], s30 offen offset:0 nt
    buffer_load_dwordx4 v[104:107], v1, s[16:19], s30 offen offset:128 nt
    buffer_load_dwordx4 v[108:111], v1, s[16:19], s30 offen offset:2048 nt
    buffer_load_dwordx4 v[112:115], v1, s[16:19], s30 offen offset:2176 nt
    s_and_b32 s46, s31, 3
    s_cbranch_scc1 L_lf4
    v_add_u32 v14, 1, v14
    buffer_store_dword v14, v17, s[72:75], 0 offen
L_lf4:
    s_add_u32 s30, s30, 4096
    s_waitcnt lgkmcnt(0)
    ds_read_b64 v[44:45], v9 offset:1024
    v_fma_f32 v46, v46, s32, v3
    v_fma_f32 v47, v47, s32, v3
    v_exp_f32 v46, v46
    v_exp_f32 v47, v47
    v_cvt_pk_bf16_f32 v51, v46, v46
    v_add_f32 v4, v4, v46
    v_cvt_pk_bf16_f32 v55, v47, v47
    v_add_f32 v4, v4, v47
    v_and_b32 v48, v51, v28
    v_and_b32 v49, v51, v29
    v_and_b32 v50, v51, v30
    v_and_b32 v51, v51, v31
    v_and_b32 v52, v55, v28
    v_and_b32 v53, v55, v29
    v_and_b32 v54, v55, v30
    v_and_b32 v55, v55, v31
    s_waitcnt vmcnt(22)
    s_bitcmp1_b32 s43, 1
    s_cbranch_scc1 L_wv1
    s_waitcnt vmcnt(18)
L_wv1:
    s_nop 0
    v_mfma_f32_16x16x32_bf16 v[20:23], v[116:119], v[48:51], v[20:23]
    v_mfma_f32_16x16x32_bf16 v[24:27], v[120:123], v[48:51], v[24:27]
    v_mfma_f32_16x16x32_bf16 v[20:23], v[124:127], v[52:55], v[20:23]
    v_mfma_f32_16x16x32_bf16 v[24:27], v[128:131], v[52:55], v[24:27]
    buffer_load_dwordx4 v[116:119], v1, s[16:19], s30 offen offset:0 nt
    buffer_load_dwordx4 v[120:123], v1, s[16:19], s30 offen offset:128 nt
    buffer_load_dwordx4 v[124:127], v1, s[16:19], s30 offen offset:2048 nt
    buffer_load_dwordx4 v[128:131], v1, s[16:19], s30 offen offset:2176 nt
    s_add_u32 s30, s30, 4096
    s_waitcnt lgkmcnt(0)
    ds_read_b64 v[46:47], v9 offset:1536
    v_fma_f32 v44, v44, s32, v3
    v_fma_f32 v45, v45, s32, v3
    v_exp_f32 v44, v44
    v_exp_f32 v45, v45
    v_cvt_pk_bf16_f32 v51, v44, v44
    v_add_f32 v4, v4, v44
    v_cvt_pk_bf16_f32 v55, v45, v45
    v_add_f32 v4, v4, v45
    v_and_b32 v48, v51, v28
    v_and_b32 v49, v51, v29
    v_and_b32 v50, v51, v30
    v_and_b32 v51, v51, v31
    v_and_b32 v52, v55, v28
    v_and_b32 v53, v55, v29
    v_and_b32 v54, v55, v30
    v_and_b32 v55, v55, v31
    s_waitcnt vmcnt(22)
    s_bitcmp1_b32 s43, 2
    s_cbranch_scc1 L_wv2
    s_waitcnt vmcnt(18)
L_wv2:
    s_nop 0
    v_mfma_f32_16x16x32_bf16 v[20:23], v[132:135], v[48:51], v[20:23]
    v_mfma_f32_16x16x32_bf16 v[24:27], v[136:139], v[48:51], v[24:27]
    v_mfma_f32_16x16x32_bf16 v[20:23], v[140:143], v[52:55], v[20:23]
    v_mfma_f32_16x16x32_bf16 v[24:27], v[144:147], v[52:55], v[24:27]
    buffer_load_dwordx4 v[132:135], v1, s[16:19], s30 offen offset:0 nt
    buffer_load_dwordx4 v[136:139], v1, s[16:19], s30 offen offset:128 nt
    buffer_load_dwordx4 v[140:143], v1, s[16:19], s30 offen offset:2048 nt
    buffer_load_dwordx4 v[144:147], v1, s[16:19], s30 offen offset:2176 nt
    s_add_u32 s30, s30, 4096
    s_waitcnt lgkmcnt(0)
    ds_read_b64 v[44:45], v9 offset:2048
    v_fma_f32 v46, v46, s32, v3
    v_fma_f32 v47, v47, s32, v3
    v_exp_f32 v46, v46
    v_exp_f32 v47, v47
    v_cvt_pk_bf16_f32 v51, v46, v46
    v_add_f32 v4, v4, v46
    v_cvt_pk_bf16_f32 v55, v47, v47
    v_add_f32 v4, v4, v47
    v_and_b32 v48, v51, v28
    v_and_b32 v49, v51, v29
    v_and_b32 v50, v51, v30
    v_and_b32 v51, v51, v31
    v_and_b32 v52, v55, v28
    v_and_b32 v53, v55, v29
    v_and_b32 v54, v55, v30
    v_and_b32 v55, v55, v31
    s_waitcnt vmcnt(22)
    s_bitcmp1_b32 s43, 3
    s_cbranch_scc1 L_wv3
    s_waitcnt vmcnt(18)
L_wv3:
    s_nop 0
    v_mfma_f32_16x16x32_bf16 v[20:23], v[148:151], v[48:51], v[20:23]
    v_mfma_f32_16x16x32_bf16 v[24:27], v[152:155], v[48:51], v[24:27]
    v_mfma_f32_16x16x32_bf16 v[20:23], v[156:159], v[52:55], v[20:23]
    v_mfma_f32_16x16x32_bf16 v[24:27], v[160:163], v[52:55], v[24:27]
    buffer_load_dwordx4 v[148:151], v1, s[16:19], s30 offen offset:0 nt
    buffer_load_dwordx4 v[152:155], v1, s[16:19], s30 offen offset:128 nt
    buffer_load_dwordx4 v[156:159], v1, s[16:19], s30 offen offset:2048 nt
    buffer_load_dwordx4 v[160:163], v1, s[16:19], s30 offen offset:2176 nt
    s_add_u32 s30, s30, 4096
    s_waitcnt lgkmcnt(0)
    ds_read_b64 v[46:47], v9 offset:2560
    v_fma_f32 v44, v44, s32, v3
    v_fma_f32 v45, v45, s32, v3
    v_exp_f32 v44, v44
    v_exp_f32 v45, v45
    v_cvt_pk_bf16_f32 v51, v44, v44
    v_add_f32 v4, v4, v44
    v_cvt_pk_bf16_f32 v55, v45, v45
    v_add_f32 v4, v4, v45
    v_and_b32 v48, v51, v28
    v_and_b32 v49, v51, v29
    v_and_b32 v50, v51, v30
    v_and_b32 v51, v51, v31
    v_and_b32 v52, v55, v28
    v_and_b32 v53, v55, v29
    v_and_b32 v54, v55, v30
    v_and_b32 v55, v55, v31
    s_waitcnt vmcnt(22)
    s_bitcmp1_b32 s43, 4
    s_cbranch_scc1 L_wv4
    s_waitcnt vmcnt(18)
L_wv4:
    s_nop 0
    v_mfma_f32_16x16x32_bf16 v[20:23], v[164:167], v[48:51], v[20:23]
    v_mfma_f32_16x16x32_bf16 v[24:27], v[168:171], v[48:51], v[24:27]
    v_mfma_f32_16x16x32_bf16 v[20:23], v[172:175], v[52:55], v[20:23]
    v_mfma_f32_16x16x32_bf16 v[24:27], v[176:179], v[52:55], v[24:27]
    buffer_load_dwordx4 v[164:167], v1, s[16:19], s30 offen offset:0 nt
    buffer_load_dwordx4 v[168:171], v1, s[16:19], s30 offen offset:128 nt
    buffer_load_dwordx4 v[172:175], v1, s[16:19], s30 offen offset:2048 nt
    buffer_load_dwordx4 v[176:179], v1, s[16:19], s30 offen offset:2176 nt
    s_and_b32 s46, s31, 3
    s_cbranch_scc1 L_lf5
    v_sub_u32 v18, v15, v14
    v_cmp_gt_u32 vcc, 8, v18
    v_subrev_u32 v18, 1, v18
    s_bcnt1_i32_b64 s46, vcc
    v_cmp_gt_u32 vcc, 7, v18
    s_nop 0
    s_bcnt1_i32_b64 s47, vcc
    s_add_u32 s46, s46, s47
    s_sub_i32 s46, s46, 2
    s_max_i32 s46, s46, 0
    s_mul_i32 s46, s46, 4
    s_add_u32 s46, s46, s78
    s_min_u32 s46, s46, 71
    s_and_b32 s46, s46, 0xf8
    s_cselect_b32 s43, 0xff, 0
    s_sub_u32 s46, s46, 8
    s_lshr_b64 s[46:47], s[76:77], s46
    s_and_b32 s43, s43, s46
L_lf5:
    s_and_b32 s46, s31, 3
    s_cmp_lg_u32 s46, 1
    s_cbranch_scc1 L_lf6
    buffer_load_dword v15, v16, s[72:75], 0 offen sc1
L_lf6:
    s_add_u32 s30, s30, 4096
    s_waitcnt lgkmcnt(0)
    ds_read_b64 v[44:45], v9 offset:3072
    v_fma_f32 v46, v46, s32, v3
    v_fma_f32 v47, v47, s32, v3
    v_exp_f32 v46, v46
    v_exp_f32 v47, v47
    v_cvt_pk_bf16_f32 v51, v46, v46
    v_add_f32 v4, v4, v46
    v_cvt_pk_bf16_f32 v55, v47, v47
    v_add_f32 v4, v4, v47
    v_and_b32 v48, v51, v28
    v_and_b32 v49, v51, v29
    v_and_b32 v50, v51, v30
    v_and_b32 v51, v51, v31
    v_and_b32 v52, v55, v28
    v_and_b32 v53, v55, v29
    v_and_b32 v54, v55, v30
    v_and_b32 v55, v55, v31
    s_waitcnt vmcnt(22)
    s_bitcmp1_b32 s43, 5
    s_cbranch_scc1 L_wv5
    s_waitcnt vmcnt(18)
L_wv5:
    s_nop 0
    v_mfma_f32_16x16x32_bf16 v[20:23], v[180:183], v[48:51], v[20:23]
    v_mfma_f32_16x16x32_bf16 v[24:27], v[184:187], v[48:51], v[24:27]
    v_mfma_f32_16x16x32_bf16 v[20:23], v[188:191], v[52:55], v[20:23]
    v_mfma_f32_16x16x32_bf16 v[24:27], v[192:195], v[52:55], v[24:27]
    buffer_load_dwordx4 v[180:183], v1, s[16:19], s30 offen offset:0 nt
    buffer_load_dwordx4 v[184:187], v1, s[16:19], s30 offen offset:128 nt
    buffer_load_dwordx4 v[188:191], v1, s[16:19], s30 offen offset:2048 nt
    buffer_load_dwordx4 v[192:195], v1, s[16:19], s30 offen offset:2176 nt
    s_add_u32 s30, s30, 4096
    s_waitcnt lgkmcnt(0)
    ds_read_b64 v[46:47], v9 offset:3584
    v_fma_f32 v44, v44, s32, v3
    v_fma_f32 v45, v45, s32, v3
    v_exp_f32 v44, v44
    v_exp_f32 v45, v45
    v_cvt_pk_bf16_f32 v51, v44, v44
    v_add_f32 v4, v4, v44
    v_cvt_pk_bf16_f32 v55, v45, v45
    v_add_f32 v4, v4, v45
    v_and_b32 v48, v51, v28
    v_and_b32 v49, v51, v29
    v_and_b32 v50, v51, v30
    v_and_b32 v51, v51, v31
    v_and_b32 v52, v55, v28
    v_and_b32 v53, v55, v29
    v_and_b32 v54, v55, v30
    v_and_b32 v55, v55, v31
    s_waitcnt vmcnt(22)
    s_bitcmp1_b32 s43, 6
    s_cbranch_scc1 L_wv6
    s_waitcnt vmcnt(18)
L_wv6:
    s_nop 0
    v_mfma_f32_16x16x32_bf16 v[20:23], v[196:199], v[48:51], v[20:23]
    v_mfma_f32_16x16x32_bf16 v[24:27], v[200:203], v[48:51], v[24:27]
    v_mfma_f32_16x16x32_bf16 v[20:23], v[204:207], v[52:55], v[20:23]
    v_mfma_f32_16x16x32_bf16 v[24:27], v[208:211], v[52:55], v[24:27]
    buffer_load_dwordx4 v[196:199], v1, s[16:19], s30 offen offset:0 nt
    buffer_load_dwordx4 v[200:203], v1, s[16:19], s30 offen offset:128 nt
    buffer_load_dwordx4 v[204:207], v1, s[16:19], s30 offen offset:2048 nt
    buffer_load_dwordx4 v[208:211], v1, s[16:19], s30 offen offset:2176 nt
    s_add_u32 s30, s30, 4096
    s_waitcnt lgkmcnt(0)
    ds_read_b64 v[44:45], v9 offset:4096
    v_fma_f32 v46, v46, s32, v3
    v_fma_f32 v47, v47, s32, v3
    v_exp_f32 v46, v46
    v_exp_f32 v47, v47
    v_cvt_pk_bf16_f32 v51, v46, v46
    v_add_f32 v4, v4, v46
    v_cvt_pk_bf16_f32 v55, v47, v47
    v_add_f32 v4, v4, v47
    v_and_b32 v48, v51, v28
    v_and_b32 v49, v51, v29
    v_and_b32 v50, v51, v30
    v_and_b32 v51, v51, v31
    v_and_b32 v52, v55, v28
    v_and_b32 v53, v55, v29
    v_and_b32 v54, v55, v30
    v_and_b32 v55, v55, v31
    s_waitcnt vmcnt(22)
    s_bitcmp1_b32 s43, 7
    s_cbranch_scc1 L_wv7
    s_waitcnt vmcnt(18)
L_wv7:
    s_nop 0
    v_mfma_f32_16x16x32_bf16 v[20:23], v[212:215], v[48:51], v[20:23]
    v_mfma_f32_16x16x32_bf16 v[24:27], v[216:219], v[48:51], v[24:27]
    v_mfma_f32_16x16x32_bf16 v[20:23], v[220:223], v[52:55], v[20:23]
    v_mfma_f32_16x16x32_bf16 v[24:27], v[224:227], v[52:55], v[24:27]
    buffer_load_dwordx4 v[212:215], v1, s[16:19], s30 offen offset:0 nt
    buffer_load_dwordx4 v[216:219], v1, s[16:19], s30 offen offset:128 nt
    buffer_load_dwordx4 v[220:223], v1, s[16:19], s30 offen offset:2048 nt
    buffer_load_dwordx4 v[224:227], v1, s[16:19], s30 offen offset:2176 nt
    s_add_u32 s30, s30, 4096
    v_add_u32 v9, 4096, v9
    s_sub_u32 s31, s31, 1
    s_branch L_v
L_vT:
    s_cmp_eq_u32 s31, 1
    s_cselect_b32 s18, 0, s18
    s_waitcnt lgkmcnt(0)
    ds_read_b64 v[46:47], v9 offset:512
    v_fma_f32 v44, v44, s32, v3
    v_fma_f32 v45, v45, s32, v3
    v_exp_f32 v44, v44
    v_exp_f32 v45, v45
    v_cvt_pk_bf16_f32 v51, v44, v44
    v_add_f32 v4, v4, v44
    v_cvt_pk_bf16_f32 v55, v45, v45
    v_add_f32 v4, v4, v45
    v_and_b32 v48, v51, v28
    v_and_b32 v49, v51, v29
    v_and_b32 v50, v51, v30
    v_and_b32 v51, v51, v31
    v_and_b32 v52, v55, v28
    v_and_b32 v53, v55, v29
    v_and_b32 v54, v55, v30
    v_and_b32 v55, v55, v31
    s_waitcnt vmcnt(28)
    s_nop 0
    v_mfma_f32_16x16x32_bf16 v[20:23], v[100:103], v[48:51], v[20:23]
    v_mfma_f32_16x16x32_bf16 v[24:27], v[104:107], v[48:51], v[24:27]
    v_mfma_f32_16x16x32_bf16 v[20:23], v[108:111], v[52:55], v[20:23]
    v_mfma_f32_16x16x32_bf16 v[24:27], v[112:115], v[52:55], v[24:27]
    buffer_load_dwordx4 v[100:103], v1, s[16:19], s30 offen offset:0 nt
    buffer_load_dwordx4 v[104:107], v1, s[16:19], s30 offen offset:128 nt
    buffer_load_dwordx4 v[108:111], v1, s[16:19], s30 offen offset:2048 nt
    buffer_load_dwordx4 v[112:115], v1, s[16:19], s30 offen offset:2176 nt
    s_cmp_lg_u32 s31, 1
    s_cbranch_scc1 L_lf7
    buffer_store_dword v11, v17, s[72:75], 0 offen
L_lf7:
    s_add_u32 s30, s30, 4096
    s_waitcnt lgkmcnt(0)
    ds_read_b64 v[44:45], v9 offset:1024
    v_fma_f32 v46, v46, s32, v3
    v_fma_f32 v47, v47, s32, v3
    v_exp_f32 v46, v46
    v_exp_f32 v47, v47
    v_cvt_pk_bf16_f32 v51, v46, v46
    v_add_f32 v4, v4, v46
    v_cvt_pk_bf16_f32 v55, v47, v47
    v_add_f32 v4, v4, v47
    v_and_b32 v48, v51, v28
    v_and_b32 v49, v51, v29
    v_and_b32 v50, v51, v30
    v_and_b32 v51, v51, v31
    v_and_b32 v52, v55, v28
    v_and_b32 v53, v55, v29
    v_and_b32 v54, v55, v30
    v_and_b32 v55, v55, v31
    s_waitcnt vmcnt(28)
    s_nop 0
    v_mfma_f32_16x16x32_bf16 v[20:23], v[116:119], v[48:51], v[20:23]
    v_mfma_f32_16x16x32_bf16 v[24:27], v[120:123], v[48:51], v[24:27]
    v_mfma_f32_16x16x32_bf16 v[20:23], v[124:127], v[52:55], v[20:23]
    v_mfma_f32_16x16x32_bf16 v[24:27], v[128:131], v[52:55], v[24:27]
    buffer_load_dwordx4 v[116:119], v1, s[16:19], s30 offen offset:0 nt
    buffer_load_dwordx4 v[120:123], v1, s[16:19], s30 offen offset:128 nt
    buffer_load_dwordx4 v[124:127], v1, s[16:19], s30 offen offset:2048 nt
    buffer_load_dwordx4 v[128:131], v1, s[16:19], s30 offen offset:2176 nt
    s_add_u32 s30, s30, 4096
    s_waitcnt lgkmcnt(0)
    ds_read_b64 v[46:47], v9 offset:1536
    v_fma_f32 v44, v44, s32, v3
    v_fma_f32 v45, v45, s32, v3
    v_exp_f32 v44, v44
    v_exp_f32 v45, v45
    v_cvt_pk_bf16_f32 v51, v44, v44
    v_add_f32 v4, v4, v44
    v_cvt_pk_bf16_f32 v55, v45, v45
    v_add_f32 v4, v4, v45
    v_and_b32 v48, v51, v28
    v_and_b32 v49, v51, v29
    v_and_b32 v50, v51, v30
    v_and_b32 v51, v51, v31
    v_and_b32 v52, v55, v28
    v_and_b32 v53, v55, v29
    v_and_b32 v54, v55, v30
    v_and_b32 v55, v55, v31
    s_waitcnt vmcnt(28)
    s_nop 0
    v_mfma_f32_16x16x32_bf16 v[20:23], v[132:135], v[48:51], v[20:23]
    v_mfma_f32_16x16x32_bf16 v[24:27], v[136:139], v[48:51], v[24:27]
    v_mfma_f32_16x16x32_bf16 v[20:23], v[140:143], v[52:55], v[20:23]
    v_mfma_f32_16x16x32_bf16 v[24:27], v[144:147], v[52:55], v[24:27]
    buffer_load_dwordx4 v[132:135], v1, s[16:19], s30 offen offset:0 nt
    buffer_load_dwordx4 v[136:139], v1, s[16:19], s30 offen offset:128 nt
    buffer_load_dwordx4 v[140:143], v1, s[16:19], s30 offen offset:2048 nt
    buffer_load_dwordx4 v[144:147], v1, s[16:19], s30 offen offset:2176 nt
    s_add_u32 s30, s30, 4096
    s_waitcnt lgkmcnt(0)
    ds_read_b64 v[44:45], v9 offset:2048
    v_fma_f32 v46, v46, s32, v3
    v_fma_f32 v47, v47, s32, v3
    v_exp_f32 v46, v46
    v_exp_f32 v47, v47
    v_cvt_pk_bf16_f32 v51, v46, v46
    v_add_f32 v4, v4, v46
    v_cvt_pk_bf16_f32 v55, v47, v47
    v_add_f32 v4, v4, v47
    v_and_b32 v48, v51, v28
    v_and_b32 v49, v51, v29
    v_and_b32 v50, v51, v30
    v_and_b32 v51, v51, v31
    v_and_b32 v52, v55, v28
    v_and_b32 v53, v55, v29
    v_and_b32 v54, v55, v30
    v_and_b32 v55, v55, v31
    s_waitcnt vmcnt(28)
    s_nop 0
    v_mfma_f32_16x16x32_bf16 v[20:23], v[148:151], v[48:51], v[20:23]
    v_mfma_f32_16x16x32_bf16 v[24:27], v[152:155], v[48:51], v[24:27]
    v_mfma_f32_16x16x32_bf16 v[20:23], v[156:159], v[52:55], v[20:23]
    v_mfma_f32_16x16x32_bf16 v[24:27], v[160:163], v[52:55], v[24:27]
    buffer_load_dwordx4 v[148:151], v1, s[16:19], s30 offen offset:0 nt
    buffer_load_dwordx4 v[152:155], v1, s[16:19], s30 offen offset:128 nt
    buffer_load_dwordx4 v[156:159], v1, s[16:19], s30 offen offset:2048 nt
    buffer_load_dwordx4 v[160:163], v1, s[16:19], s30 offen offset:2176 nt
    s_add_u32 s30, s30, 4096
    s_waitcnt lgkmcnt(0)
    ds_read_b64 v[46:47], v9 offset:2560
    v_fma_f32 v44, v44, s32, v3
    v_fma_f32 v45, v45, s32, v3
    v_exp_f32 v44, v44
    v_exp_f32 v45, v45
    v_cvt_pk_bf16_f32 v51, v44, v44
    v_add_f32 v4, v4, v44
    v_cvt_pk_bf16_f32 v55, v45, v45
    v_add_f32 v4, v4, v45
    v_and_b32 v48, v51, v28
    v_and_b32 v49, v51, v29
    v_and_b32 v50, v51, v30
    v_and_b32 v51, v51, v31
    v_and_b32 v52, v55, v28
    v_and_b32 v53, v55, v29
    v_and_b32 v54, v55, v30
    v_and_b32 v55, v55, v31
    s_waitcnt vmcnt(28)
    s_nop 0
    v_mfma_f32_16x16x32_bf16 v[20:23], v[164:167], v[48:51], v[20:23]
    v_mfma_f32_16x16x32_bf16 v[24:27], v[168:171], v[48:51], v[24:27]
    v_mfma_f32_16x16x32_bf16 v[20:23], v[172:175], v[52:55], v[20:23]
    v_mfma_f32_16x16x32_bf16 v[24:27], v[176:179], v[52:55], v[24:27]
    buffer_load_dwordx4 v[164:167], v1, s[16:19], s30 offen offset:0 nt
    buffer_load_dwordx4 v[168:171], v1, s[16:19], s30 offen offset:128 nt
    buffer_load_dwordx4 v[172:175], v1, s[16:19], s30 offen offset:2048 nt
    buffer_load_dwordx4 v[176:179], v1, s[16:19], s30 offen offset:2176 nt
    s_add_u32 s30, s30, 4096
    s_waitcnt lgkmcnt(0)
    ds_read_b64 v[44:45], v9 offset:3072
    v_fma_f32 v46, v46, s32, v3
    v_fma_f32 v47, v47, s32, v3
    v_exp_f32 v46, v46
    v_exp_f32 v47, v47
    v_cvt_pk_bf16_f32 v51, v46, v46
    v_add_f32 v4, v4, v46
    v_cvt_pk_bf16_f32 v55, v47, v47
    v_add_f32 v4, v4, v47
    v_and_b32 v48, v51, v28
    v_and_b32 v49, v51, v29
    v_and_b32 v50, v51, v30
    v_and_b32 v51, v51, v31
    v_and_b32 v52, v55, v28
    v_and_b32 v53, v55, v29
    v_and_b32 v54, v55, v30
    v_and_b32 v55, v55, v31
    s_waitcnt vmcnt(28)
    s_nop 0
    v_mfma_f32_16x16x32_bf16 v[20:23], v[180:183], v[48:51], v[20:23]
    v_mfma_f32_16x16x32_bf16 v[24:27], v[184:187], v[48:51], v[24:27]
    v_mfma_f32_16x16x32_bf16 v[20:23], v[188:191], v[52:55], v[20:23]
    v_mfma_f32_16x16x32_bf16 v[24:27], v[192:195], v[52:55], v[24:27]
    buffer_load_dwordx4 v[180:183], v1, s[16:19], s30 offen offset:0 nt
    buffer_load_dwordx4 v[184:187], v1, s[16:19], s30 offen offset:128 nt
    buffer_load_dwordx4 v[188:191], v1, s[16:19], s30 offen offset:2048 nt
    buffer_load_dwordx4 v[192:195], v1, s[16:19], s30 offen offset:2176 nt
    s_add_u32 s30, s30, 4096
    s_waitcnt lgkmcnt(0)
    ds_read_b64 v[46:47], v9 offset:3584
    v_fma_f32 v44, v44, s32, v3
    v_fma_f32 v45, v45, s32, v3
    v_exp_f32 v44, v44
    v_exp_f32 v45, v45
    v_cvt_pk_bf16_f32 v51, v44, v44
    v_add_f32 v4, v4, v44
    v_cvt_pk_bf16_f32 v55, v45, v45
    v_add_f32 v4, v4, v45
    v_and_b32 v48, v51, v28
    v_and_b32 v49, v51, v29
    v_and_b32 v50, v51, v30
    v_and_b32 v51, v51, v31
    v_and_b32 v52, v55, v28
    v_and_b32 v53, v55, v29
    v_and_b32 v54, v55, v30
    v_and_b32 v55, v55, v31
    s_waitcnt vmcnt(28)
    s_nop 0
    v_mfma_f32_16x16x32_bf16 v[20:23], v[196:199], v[48:51], v[20:23]
    v_mfma_f32_16x16x32_bf16 v[24:27], v[200:203], v[48:51], v[24:27]
    v_mfma_f32_16x16x32_bf16 v[20:23], v[204:207], v[52:55], v[20:23]
    v_mfma_f32_16x16x32_bf16 v[24:27], v[208:211], v[52:55], v[24:27]
    buffer_load_dwordx4 v[196:199], v1, s[16:19], s30 offen offset:0 nt
    buffer_load_dwordx4 v[200:203], v1, s[16:19], s30 offen offset:128 nt
    buffer_load_dwordx4 v[204:207], v1, s[16:19], s30 offen offset:2048 nt
    buffer_load_dwordx4 v[208:211], v1, s[16:19], s30 offen offset:2176 nt
    s_add_u32 s30, s30, 4096
    s_waitcnt lgkmcnt(0)
    ds_read_b64 v[44:45], v9 offset:4096
    v_fma_f32 v46, v46, s32, v3
    v_fma_f32 v47, v47, s32, v3
    v_exp_f32 v46, v46
    v_exp_f32 v47, v47
    v_cvt_pk_bf16_f32 v51, v46, v46
    v_add_f32 v4, v4, v46
    v_cvt_pk_bf16_f32 v55, v47, v47
    v_add_f32 v4, v4, v47
    v_and_b32 v48, v51, v28
    v_and_b32 v49, v51, v29
    v_and_b32 v50, v51, v30
    v_and_b32 v51, v51, v31
    v_and_b32 v52, v55, v28
    v_and_b32 v53, v55, v29
    v_and_b32 v54, v55, v30
    v_and_b32 v55, v55, v31
    s_waitcnt vmcnt(28)
    s_nop 0
    v_mfma_f32_16x16x32_bf16 v[20:23], v[212:215], v[48:51], v[20:23]
    v_mfma_f32_16x16x32_bf16 v[24:27], v[216:219], v[48:51], v[24:27]
    v_mfma_f32_16x16x32_bf16 v[20:23], v[220:223], v[52:55], v[20:23]
    v_mfma_f32_16x16x32_bf16 v[24:27], v[224:227], v[52:55], v[24:27]
    buffer_load_dwordx4 v[212:215], v1, s[16:19], s30 offen offset:0 nt
    buffer_load_dwordx4 v[216:219], v1, s[16:19], s30 offen offset:128 nt
    buffer_load_dwordx4 v[220:223], v1, s[16:19], s30 offen offset:2048 nt
    buffer_load_dwordx4 v[224:227], v1, s[16:19], s30 offen offset:2176 nt
    s_add_u32 s30, s30, 4096
    v_add_u32 v9, 4096, v9
    s_sub_u32 s31, s31, 1
    s_cmp_lg_u32 s31, 0
    s_cbranch_scc1 L_v
    v_add_f32_dpp v4, v4, v4 row_ror:8 row_mask:0xf bank_mask:0xf
    v_lshrrev_b32 v6, 5, v0
    v_lshlrev_b32 v6, 9, v6
    v_add_f32_dpp v4, v4, v4 row_bcast:15 row_mask:0xa bank_mask:0xf
    v_bfe_u32 v7, v0, 4, 1
    v_lshl_add_u32 v6, v7, 7, v6
    v_add_f32_dpp v4, v4, v4 row_bcast:31 row_mask:0xc bank_mask:0xf
    v_and_b32 v7, 7, v0
    v_lshl_add_u32 v6, v7, 2, v6
    v_add_u32 v6, 131584, v6
    v_readlane_b32 s33, v4, 63
    s_mov_b32 exec_lo, 0x00ff00ff
    s_mov_b32 exec_hi, 0xff00ff00
    ds_write2_b32 v6, v20, v21 offset0:0 offset1:8
    ds_write2_b32 v6, v22, v23 offset0:16 offset1:24
    ds_write2_b32 v6, v24, v25 offset0:64 offset1:72
    ds_write2_b32 v6, v26, v27 offset0:80 offset1:88
    s_mov_b64 exec, -1
    v_add_u32 v6, 131584, v8
    ds_read2st64_b64 v[32:35], v6 offset0:0 offset1:1
    v_and_b32 v7, 1, v0
    v_cmp_eq_u32 vcc, 1, v7
    v_mov_b32 v4, s33
    s_mov_b32 s16, s10
    s_and_b32 s17, s11, 0xffff
    s_mov_b32 s18, 8192
    v_mov_b32 v7, 1
    v_lshlrev_b32 v6, 2, v0
    v_add_u32 v51, 1, v56
    v_cndmask_b32 v50, v2, v4, vcc
    s_waitcnt lgkmcnt(0)
    v_pk_add_f32 v[48:49], v[32:33], v[34:35]
    buffer_store_dwordx4 v[48:51], v12, s[24:27], s56 offen sc1
    buffer_load_dwordx4 v[64:67], v12, s[24:27], s57 offen sc1
    buffer_load_dwordx4 v[68:71], v12, s[24:27], s58 offen sc1
    buffer_load_dwordx4 v[72:75], v12, s[24:27], s59 offen sc1
    buffer_load_dwordx4 v[76:79], v12, s[24:27], s60 offen sc1
    buffer_load_dwordx4 v[80:83], v12, s[24:27], s61 offen sc1
    buffer_load_dwordx4 v[84:87], v12, s[24:27], s62 offen sc1
    buffer_load_dwordx4 v[88:91], v12, s[24:27], s63 offen sc1
    s_mov_b64 exec, 0
    s_branch L_final
L_chk:
    s_mov_b64 exec, -1
    s_waitcnt vmcnt(0)
    v_xor_b32 v93, v67, v57
    v_xor_b32 v94, v71, v58
    v_xor_b32 v95, v75, v59
    v_xor_b32 v96, v79, v60
    v_xor_b32 v97, v83, v61
    v_xor_b32 v98, v87, v62
    v_xor_b32 v99, v91, v63
    v_min3_u32 v92, v93, v94, v95
    v_min3_u32 v96, v96, v97, v98
    v_min3_u32 v92, v92, v96, v99
    v_cmp_eq_u32 vcc, 0, v92
    s_nop 1
    s_cbranch_vccnz L_slow
L_final:
    v_max3_f32 v5, v50, v66, v70
    v_max3_f32 v4, v74, v78, v82
    v_max3_f32 v5, v5, v86, v90
    v_max_f32 v5, v5, v4
    v_sub_f32 v92, v50, v5
    v_sub_f32 v93, v66, v5
    v_sub_f32 v94, v70, v5
    v_sub_f32 v95, v74, v5
    v_sub_f32 v96, v78, v5
    v_sub_f32 v97, v82, v5
    v_sub_f32 v98, v86, v5
    v_sub_f32 v99, v90, v5
    v_mul_f32 v92, s32, v92
    v_mul_f32 v93, s32, v93
    v_mul_f32 v94, s32, v94
    v_mul_f32 v95, s32, v95
    v_mul_f32 v96, s32, v96
    v_mul_f32 v97, s32, v97
    v_mul_f32 v98, s32, v98
    v_mul_f32 v99, s32, v99
    v_exp_f32 v92, v92
    v_exp_f32 v93, v93
    v_exp_f32 v94, v94
    v_exp_f32 v95, v95
    v_exp_f32 v96, v96
    v_exp_f32 v97, v97
    v_exp_f32 v98, v98
    v_exp_f32 v99, v99
    s_nop 1
    v_mul_f32_dpp v48, v92, v48 quad_perm:[0,0,2,2] row_mask:0xf bank_mask:0xf
    v_mul_f32_dpp v49, v92, v49 quad_perm:[0,0,2,2] row_mask:0xf bank_mask:0xf
    v_mul_f32_dpp v50, v92, v50 quad_perm:[0,0,2,2] row_mask:0xf bank_mask:0xf
    v_mul_f32_dpp v64, v93, v64 quad_perm:[0,0,2,2] row_mask:0xf bank_mask:0xf
    v_mul_f32_dpp v65, v93, v65 quad_perm:[0,0,2,2] row_mask:0xf bank_mask:0xf
    v_mul_f32_dpp v66, v93, v66 quad_perm:[0,0,2,2] row_mask:0xf bank_mask:0xf
    v_mul_f32_dpp v68, v94, v68 quad_perm:[0,0,2,2] row_mask:0xf bank_mask:0xf
    v_mul_f32_dpp v69, v94, v69 quad_perm:[0,0,2,2] row_mask:0xf bank_mask:0xf
    v_mul_f32_dpp v70, v94, v70 quad_perm:[0,0,2,2] row_mask:0xf bank_mask:0xf
    v_mul_f32_dpp v72, v95, v72 quad_perm:[0,0,2,2] row_mask:0xf bank_mask:0xf
    v_mul_f32_dpp v73, v95, v73 quad_perm:[0,0,2,2] row_mask:0xf bank_mask:0xf
    v_mul_f32_dpp v74, v95, v74 quad_perm:[0,0,2,2] row_mask:0xf bank_mask:0xf
    v_mul_f32_dpp v76, v96, v76 quad_perm:[0,0,2,2] row_mask:0xf bank_mask:0xf
    v_mul_f32_dpp v77, v96, v77 quad_perm:[0,0,2,2] row_mask:0xf bank_mask:0xf
    v_mul_f32_dpp v78, v96, v78 quad_perm:[0,0,2,2] row_mask:0xf bank_mask:0xf
    v_mul_f32_dpp v80, v97, v80 quad_perm:[0,0,2,2] row_mask:0xf bank_mask:0xf
    v_mul_f32_dpp v81, v97, v81 quad_perm:[0,0,2,2] row_mask:0xf bank_mask:0xf
    v_mul_f32_dpp v82, v97, v82 quad_perm:[0,0,2,2] row_mask:0xf bank_mask:0xf
    v_mul_f32_dpp v84, v98, v84 quad_perm:[0,0,2,2] row_mask:0xf bank_mask:0xf
    v_mul_f32_dpp v85, v98, v85 quad_perm:[0,0,2,2] row_mask:0xf bank_mask:0xf
    v_mul_f32_dpp v86, v98, v86 quad_perm:[0,0,2,2] row_mask:0xf bank_mask:0xf
    v_mul_f32_dpp v88, v99, v88 quad_perm:[0,0,2,2] row_mask:0xf bank_mask:0xf
    v_mul_f32_dpp v89, v99, v89 quad_perm:[0,0,2,2] row_mask:0xf bank_mask:0xf
    v_mul_f32_dpp v90, v99, v90 quad_perm:[0,0,2,2] row_mask:0xf bank_mask:0xf
    v_add_f32 v50, v50, v66
    v_add_f32 v70, v70, v74
    v_add_f32 v78, v78, v82
    v_add_f32 v86, v86, v90
    v_pk_add_f32 v[48:49], v[48:49], v[64:65]
    v_pk_add_f32 v[68:69], v[68:69], v[72:73]
    v_pk_add_f32 v[76:77], v[76:77], v[80:81]
    v_pk_add_f32 v[84:85], v[84:85], v[88:89]
    v_add_f32 v50, v50, v70
    v_add_f32 v78, v78, v86
    v_pk_add_f32 v[48:49], v[48:49], v[68:69]
    v_pk_add_f32 v[76:77], v[76:77], v[84:85]
    v_add_f32 v50, v50, v78
    v_pk_add_f32 v[48:49], v[48:49], v[76:77]
    v_rcp_f32 v50, v50
    s_nop 1
    v_mul_f32_dpp v48, v50, v48 quad_perm:[1,1,3,3] row_mask:0xf bank_mask:0xf
    v_mul_f32_dpp v49, v50, v49 quad_perm:[1,1,3,3] row_mask:0xf bank_mask:0xf
    v_cvt_pk_bf16_f32 v48, v48, v49
    s_cbranch_execz L_chk
    buffer_store_dword v48, v6, s[16:19], s36 offen
L_fin:
L_end:
    s_endpgm
L_slow:
    buffer_load_dwordx4 v[64:67], v12, s[24:27], s57 offen sc1
    buffer_load_dwordx4 v[68:71], v12, s[24:27], s58 offen sc1
    buffer_load_dwordx4 v[72:75], v12, s[24:27], s59 offen sc1
    buffer_load_dwordx4 v[76:79], v12, s[24:27], s60 offen sc1
    buffer_load_dwordx4 v[80:83], v12, s[24:27], s61 offen sc1
    buffer_load_dwordx4 v[84:87], v12, s[24:27], s62 offen sc1
    buffer_load_dwordx4 v[88:91], v12, s[24:27], s63 offen sc1
    s_mov_b64 exec, 1
    buffer_atomic_add v7, v11, s[20:23], s35 offen offset:4 sc0
    s_mov_b64 exec, -1
    s_waitcnt vmcnt(1)
    v_xor_b32 v93, v67, v57
    v_xor_b32 v94, v71, v58
    v_xor_b32 v95, v75, v59
    v_xor_b32 v96, v79, v60
    v_xor_b32 v97, v83, v61
    v_xor_b32 v98, v87, v62
    v_xor_b32 v99, v91, v63
    v_min3_u32 v92, v93, v94, v95
    v_min3_u32 v96, v96, v97, v98
    v_min3_u32 v92, v92, v96, v99
    v_cmp_eq_u32 vcc, 0, v92
    s_nop 1
    s_cbranch_vccz L_final
    s_waitcnt vmcnt(0)
    v_readfirstlane_b32 s33, v7
    s_nop 3
    s_cmp_lg_u32 s33, 7
    s_cbranch_scc1 L_fin
    buffer_load_dwordx4 v[64:67], v12, s[24:27], s57 offen sc1
    buffer_load_dwordx4 v[68:71], v12, s[24:27], s58 offen sc1
    buffer_load_dwordx4 v[72:75], v12, s[24:27], s59 offen sc1
    buffer_load_dwordx4 v[76:79], v12, s[24:27], s60 offen sc1
    buffer_load_dwordx4 v[80:83], v12, s[24:27], s61 offen sc1
    buffer_load_dwordx4 v[84:87], v12, s[24:27], s62 offen sc1
    buffer_load_dwordx4 v[88:91], v12, s[24:27], s63 offen sc1
    s_waitcnt vmcnt(0)
    s_branch L_final
.section .rodata,"a"
.p2align 6
.amdhsa_kernel standalone__gqa_softmax__decode_kernel
  .amdhsa_next_free_vgpr 228
  .amdhsa_next_free_sgpr 80
  .amdhsa_accum_offset 228
  .amdhsa_group_segment_fixed_size 0
  .amdhsa_kernarg_size 48
  .amdhsa_user_sgpr_count 2
  .amdhsa_user_sgpr_kernarg_segment_ptr 1
  .amdhsa_system_sgpr_workgroup_id_x 1
.end_amdhsa_kernel
```
